```python
import torch

def _softmax(x, axis=-1):
    return torch.softmax(x, dim=axis)
def _gelu(x):
    return torch.nn.functional.gelu(x, approximate="tanh")
def _silu(x):
    return torch.nn.functional.silu(x)
def _sigmoid(x):
    return torch.sigmoid(x)
def _layernorm(x, axis=-1, eps=1e-5):
    m = x.mean(dim=axis, keepdim=True)
    v = x.var(dim=axis, keepdim=True, unbiased=False)
    return (x - m) / torch.sqrt(v + eps)
def _scatter_add(tgt, idx, src, axis=0):
    return tgt.clone().index_add_(axis, idx, src)
def _segment_sum(src, seg, n):
    out = torch.zeros((n,) + src.shape[1:], dtype=src.dtype)
    return out.index_add_(0, seg, src)
def _pad(x, pw):
    flat = tuple(v for pair in reversed(pw) for v in pair)
    return torch.nn.functional.pad(x, flat)

kernel_name = 'standalone__mha_softmax__sampling'

def setup_inputs():

    _w = (lambda a: (lambda t: t.to(torch.bfloat16) if t.is_floating_point() else t)(torch.as_tensor(a)))
    B, H, Sq, Sk, D = 8, 32, 1, 8192, 128
    return {
        "q": _w((lambda *s: torch.randn(*s, dtype=torch.bfloat16) * 0.8)(B, H, Sq, D)),
        "k": _w((lambda *s: torch.randn(*s, dtype=torch.bfloat16) * 0.8)(B, H, Sk, D)),
        "v": _w((lambda *s: torch.randn(*s, dtype=torch.bfloat16) * 0.05)(B, H, Sk, D)),
    }

def reference(q, k, v):
    scale = q.shape[-1] ** -0.5
    scores = torch.einsum("bhqd,bhkd->bhqk", q, k) * scale
    p = _softmax(scores, axis=-1)
    return torch.einsum("bhqk,bhkd->bhqd", p, v)
```

```asm
; @launch grid=(256,1,1) block=(64,1,1) lds=90000
.amdgcn_target "amdgcn-amd-amdhsa--gfx950"
.text
.globl standalone__mha_softmax__sampling_kernel
.p2align 8
.type standalone__mha_softmax__sampling_kernel,@function
standalone__mha_softmax__sampling_kernel:
  s_cmp_ge_u32 s2, 256
  s_cbranch_scc1 L_end
  s_load_dwordx8 s[4:11], s[0:1], 0
  s_load_dwordx2 s[12:13], s[0:1], 32
  v_lshlrev_b32 v44, 4, v0
  v_add_u32 v45, 4096, v44
  v_add_u32 v46, 8192, v44
  v_add_u32 v47, 12288, v44
  v_add_u32 v48, 65536, v44
  v_add_u32 v49, 69632, v44
  v_add_u32 v50, 73728, v44
  v_add_u32 v51, 77824, v44
  s_lshl_b32 s37, s2, 21
  s_lshr_b32 s38, s2, 11
  s_mov_b32 s32, 0
  s_mov_b32 s33, 0x4000
  s_lshl_b32 s39, s2, 8
  v_and_b32 v33, 15, v0
  v_lshlrev_b32 v33, 4, v33
  s_mov_b32 s18, 2097152
  s_mov_b32 s19, 0x00020000
  s_mov_b32 s26, 0x10000
  s_mov_b32 s27, 0x00020000
  s_waitcnt lgkmcnt(0)
  s_add_u32 s16, s6, s37
  s_addc_u32 s17, s7, s38
  s_mov_b32 s24, s4
  s_mov_b32 s25, s5
  buffer_load_dwordx4 v[52:55], v44, s[16:19], s32 offen offset:0 nt
  buffer_load_dwordx4 v[2:5], v33, s[24:27], s39 offen nt
  buffer_load_dwordx4 v[56:59], v44, s[16:19], s32 offen offset:1024 nt
  buffer_load_dwordx4 v[60:63], v48, s[16:19], s32 offen offset:0 nt
  buffer_load_dwordx4 v[64:67], v48, s[16:19], s32 offen offset:1024 nt
  buffer_load_dwordx4 v[68:71], v44, s[16:19], s32 offen offset:2048 nt
  buffer_load_dwordx4 v[72:75], v44, s[16:19], s32 offen offset:3072 nt
  buffer_load_dwordx4 v[76:79], v48, s[16:19], s32 offen offset:2048 nt
  buffer_load_dwordx4 v[80:83], v48, s[16:19], s32 offen offset:3072 nt
  buffer_load_dwordx4 v[84:87], v45, s[16:19], s32 offen offset:0 nt
  buffer_load_dwordx4 v[88:91], v45, s[16:19], s32 offen offset:1024 nt
  buffer_load_dwordx4 v[92:95], v49, s[16:19], s32 offen offset:0 nt
  buffer_load_dwordx4 v[96:99], v49, s[16:19], s32 offen offset:1024 nt
  buffer_load_dwordx4 v[100:103], v45, s[16:19], s32 offen offset:2048 nt
  buffer_load_dwordx4 v[104:107], v45, s[16:19], s32 offen offset:3072 nt
  buffer_load_dwordx4 v[108:111], v49, s[16:19], s32 offen offset:2048 nt
  buffer_load_dwordx4 v[112:115], v49, s[16:19], s32 offen offset:3072 nt
  buffer_load_dwordx4 v[116:119], v46, s[16:19], s32 offen offset:0 nt
  buffer_load_dwordx4 v[120:123], v46, s[16:19], s32 offen offset:1024 nt
  buffer_load_dwordx4 v[124:127], v50, s[16:19], s32 offen offset:0 nt
  s_add_u32 s20, s8, s37
  s_addc_u32 s21, s9, s38
  s_mov_b32 s28, s10
  s_mov_b32 s29, s11
  s_mov_b32 s30, 0x10000
  s_mov_b32 s31, 0x00020000
  s_mov_b32 s34, 0x3e0293ee
  s_mov_b32 s56, s12
  s_mov_b32 s57, s13
  s_mov_b32 s58, 256
  s_mov_b32 s59, 0x00020000
  s_cmp_lt_u32 s2, 32
  s_cselect_b32 s60, 52, -1
  s_cselect_b32 s61, 12, -1
  s_lshl_b32 s62, s2, 3
  v_mov_b32 v35, 0
  v_cmp_lt_u32 vcc, 0, v0
  v_mov_b32 v34, 0x40000000
  s_nop 0
  v_cndmask_b32 v1, 0, v34, vcc
  v_and_b32 v28, 1, v0
  v_cmp_eq_u32 vcc, 1, v28
  v_mov_b32 v28, 0xffff
  v_mov_b32 v29, 0xffff0000
  v_cndmask_b32 v33, v28, v29, vcc
  v_bfe_u32 v34, v0, 1, 2
  v_cmp_eq_u32 vcc, 0, v34
  s_nop 1
  v_cndmask_b32 v6, 0, v33, vcc
  v_cmp_eq_u32 vcc, 1, v34
  s_nop 1
  v_cndmask_b32 v7, 0, v33, vcc
  v_cmp_eq_u32 vcc, 2, v34
  s_nop 1
  v_cndmask_b32 v8, 0, v33, vcc
  v_cmp_eq_u32 vcc, 3, v34
  s_nop 1
  v_cndmask_b32 v9, 0, v33, vcc
  v_mov_b32 v10, 0xff800000
  v_mov_b32 v12, 0
  v_mov_b32 v16, 0
  v_mov_b32 v17, 0
  v_mov_b32 v18, 0
  v_mov_b32 v19, 0
  v_mov_b32 v20, 0
  v_mov_b32 v21, 0
  v_mov_b32 v22, 0
  v_mov_b32 v23, 0
  v_and_b32 v13, 0x3c, v0
  s_mov_b32 s35, 64
  v_mov_b32 v180, 0xff800000
  v_mov_b32 v181, 0xff800000
  v_mov_b32 v182, 0xff800000
  v_mov_b32 v183, 0xff800000
  s_waitcnt vmcnt(18)
L_k:
  s_waitcnt vmcnt(18)
  buffer_load_dwordx4 v[128:131], v50, s[16:19], s32 offen offset:1024 nt
  v_dot2_f32_bf16 v24, v52, v2, 0
  v_dot2_f32_bf16 v24, v53, v3, v24
  v_dot2_f32_bf16 v24, v54, v4, v24
  v_dot2_f32_bf16 v24, v55, v5, v24
  v_add_f32_dpp v28, v180, v180 row_mirror row_mask:0xf bank_mask:0x3
  v_add_f32_dpp v29, v181, v181 row_mirror row_mask:0xf bank_mask:0x3
  v_add_f32_dpp v28, v182, v182 row_mirror row_mask:0xf bank_mask:0xc
  v_add_f32_dpp v29, v183, v183 row_mirror row_mask:0xf bank_mask:0xc
  s_waitcnt vmcnt(18)
  buffer_load_dwordx4 v[132:135], v46, s[16:19], s32 offen offset:2048 nt
  v_dot2_f32_bf16 v25, v56, v2, 0
  v_dot2_f32_bf16 v25, v57, v3, v25
  v_dot2_f32_bf16 v25, v58, v4, v25
  v_dot2_f32_bf16 v25, v59, v5, v25
  v_add_f32_dpp v30, v28, v28 row_half_mirror row_mask:0xf bank_mask:0x5
  v_add_f32_dpp v30, v29, v29 row_half_mirror row_mask:0xf bank_mask:0xa
  s_waitcnt vmcnt(18)
  buffer_load_dwordx4 v[136:139], v46, s[16:19], s32 offen offset:3072 nt
  v_dot2_f32_bf16 v26, v60, v2, 0
  v_dot2_f32_bf16 v26, v61, v3, v26
  v_dot2_f32_bf16 v26, v62, v4, v26
  v_dot2_f32_bf16 v26, v63, v5, v26
  v_add_f32_dpp v30, v30, v30 quad_perm:[2,3,0,1] row_mask:0xf bank_mask:0xf
  s_waitcnt vmcnt(18)
  buffer_load_dwordx4 v[140:143], v50, s[16:19], s32 offen offset:2048 nt
  v_dot2_f32_bf16 v27, v64, v2, 0
  v_dot2_f32_bf16 v27, v65, v3, v27
  v_dot2_f32_bf16 v27, v66, v4, v27
  v_dot2_f32_bf16 v27, v67, v5, v27
  v_add_f32_dpp v30, v30, v30 quad_perm:[1,0,3,2] row_mask:0xf bank_mask:0xf
  ds_write_b32 v13, v30 offset:0
  v_max_f32 v10, v10, v30
  s_waitcnt vmcnt(18)
  buffer_load_dwordx4 v[144:147], v50, s[16:19], s32 offen offset:3072 nt
  v_dot2_f32_bf16 v180, v68, v2, 0
  v_dot2_f32_bf16 v180, v69, v3, v180
  v_dot2_f32_bf16 v180, v70, v4, v180
  v_dot2_f32_bf16 v180, v71, v5, v180
  v_add_f32_dpp v28, v24, v24 row_mirror row_mask:0xf bank_mask:0x3
  v_add_f32_dpp v29, v25, v25 row_mirror row_mask:0xf bank_mask:0x3
  v_add_f32_dpp v28, v26, v26 row_mirror row_mask:0xf bank_mask:0xc
  v_add_f32_dpp v29, v27, v27 row_mirror row_mask:0xf bank_mask:0xc
  s_waitcnt vmcnt(18)
  buffer_load_dwordx4 v[148:151], v47, s[16:19], s32 offen offset:0 nt
  v_dot2_f32_bf16 v181, v72, v2, 0
  v_dot2_f32_bf16 v181, v73, v3, v181
  v_dot2_f32_bf16 v181, v74, v4, v181
  v_dot2_f32_bf16 v181, v75, v5, v181
  v_add_f32_dpp v30, v28, v28 row_half_mirror row_mask:0xf bank_mask:0x5
  v_add_f32_dpp v30, v29, v29 row_half_mirror row_mask:0xf bank_mask:0xa
  s_waitcnt vmcnt(18)
  buffer_load_dwordx4 v[152:155], v47, s[16:19], s32 offen offset:1024 nt
  v_dot2_f32_bf16 v182, v76, v2, 0
  v_dot2_f32_bf16 v182, v77, v3, v182
  v_dot2_f32_bf16 v182, v78, v4, v182
  v_dot2_f32_bf16 v182, v79, v5, v182
  v_add_f32_dpp v30, v30, v30 quad_perm:[2,3,0,1] row_mask:0xf bank_mask:0xf
  s_waitcnt vmcnt(18)
  buffer_load_dwordx4 v[156:159], v51, s[16:19], s32 offen offset:0 nt
  v_dot2_f32_bf16 v183, v80, v2, 0
  v_dot2_f32_bf16 v183, v81, v3, v183
  v_dot2_f32_bf16 v183, v82, v4, v183
  v_dot2_f32_bf16 v183, v83, v5, v183
  v_add_f32_dpp v30, v30, v30 quad_perm:[1,0,3,2] row_mask:0xf bank_mask:0xf
  ds_write_b32 v13, v30 offset:64
  v_max_f32 v10, v10, v30
  s_waitcnt vmcnt(18)
  buffer_load_dwordx4 v[160:163], v51, s[16:19], s32 offen offset:1024 nt
  v_dot2_f32_bf16 v24, v84, v2, 0
  v_dot2_f32_bf16 v24, v85, v3, v24
  v_dot2_f32_bf16 v24, v86, v4, v24
  v_dot2_f32_bf16 v24, v87, v5, v24
  v_add_f32_dpp v28, v180, v180 row_mirror row_mask:0xf bank_mask:0x3
  v_add_f32_dpp v29, v181, v181 row_mirror row_mask:0xf bank_mask:0x3
  v_add_f32_dpp v28, v182, v182 row_mirror row_mask:0xf bank_mask:0xc
  v_add_f32_dpp v29, v183, v183 row_mirror row_mask:0xf bank_mask:0xc
  s_waitcnt vmcnt(18)
  buffer_load_dwordx4 v[164:167], v47, s[16:19], s32 offen offset:2048 nt
  v_dot2_f32_bf16 v25, v88, v2, 0
  v_dot2_f32_bf16 v25, v89, v3, v25
  v_dot2_f32_bf16 v25, v90, v4, v25
  v_dot2_f32_bf16 v25, v91, v5, v25
  v_add_f32_dpp v30, v28, v28 row_half_mirror row_mask:0xf bank_mask:0x5
  v_add_f32_dpp v30, v29, v29 row_half_mirror row_mask:0xf bank_mask:0xa
  s_waitcnt vmcnt(18)
  buffer_load_dwordx4 v[168:171], v47, s[16:19], s32 offen offset:3072 nt
  v_dot2_f32_bf16 v26, v92, v2, 0
  v_dot2_f32_bf16 v26, v93, v3, v26
  v_dot2_f32_bf16 v26, v94, v4, v26
  v_dot2_f32_bf16 v26, v95, v5, v26
  v_add_f32_dpp v30, v30, v30 quad_perm:[2,3,0,1] row_mask:0xf bank_mask:0xf
  s_waitcnt vmcnt(18)
  buffer_load_dwordx4 v[172:175], v51, s[16:19], s32 offen offset:2048 nt
  v_dot2_f32_bf16 v27, v96, v2, 0
  v_dot2_f32_bf16 v27, v97, v3, v27
  v_dot2_f32_bf16 v27, v98, v4, v27
  v_dot2_f32_bf16 v27, v99, v5, v27
  v_add_f32_dpp v30, v30, v30 quad_perm:[1,0,3,2] row_mask:0xf bank_mask:0xf
  ds_write_b32 v13, v30 offset:128
  v_max_f32 v10, v10, v30
  s_waitcnt vmcnt(18)
  buffer_load_dwordx4 v[176:179], v51, s[16:19], s32 offen offset:3072 nt
  v_dot2_f32_bf16 v180, v100, v2, 0
  v_dot2_f32_bf16 v180, v101, v3, v180
  v_dot2_f32_bf16 v180, v102, v4, v180
  v_dot2_f32_bf16 v180, v103, v5, v180
  v_add_f32_dpp v28, v24, v24 row_mirror row_mask:0xf bank_mask:0x3
  v_add_f32_dpp v29, v25, v25 row_mirror row_mask:0xf bank_mask:0x3
  v_add_f32_dpp v28, v26, v26 row_mirror row_mask:0xf bank_mask:0xc
  v_add_f32_dpp v29, v27, v27 row_mirror row_mask:0xf bank_mask:0xc
  s_cmp_eq_u32 s35, 1
  s_cselect_b32 s16, s20, s16
  s_cselect_b32 s17, s21, s17
  s_cselect_b32 s33, 0, s33
  s_waitcnt vmcnt(18)
  buffer_load_dwordx4 v[52:55], v44, s[16:19], s33 offen offset:0 nt
  v_dot2_f32_bf16 v181, v104, v2, 0
  v_dot2_f32_bf16 v181, v105, v3, v181
  v_dot2_f32_bf16 v181, v106, v4, v181
  v_dot2_f32_bf16 v181, v107, v5, v181
  v_add_f32_dpp v30, v28, v28 row_half_mirror row_mask:0xf bank_mask:0x5
  v_add_f32_dpp v30, v29, v29 row_half_mirror row_mask:0xf bank_mask:0xa
  s_waitcnt vmcnt(18)
  buffer_load_dwordx4 v[56:59], v44, s[16:19], s33 offen offset:1024 nt
  v_dot2_f32_bf16 v182, v108, v2, 0
  v_dot2_f32_bf16 v182, v109, v3, v182
  v_dot2_f32_bf16 v182, v110, v4, v182
  v_dot2_f32_bf16 v182, v111, v5, v182
  v_add_f32_dpp v30, v30, v30 quad_perm:[2,3,0,1] row_mask:0xf bank_mask:0xf
  s_waitcnt vmcnt(18)
  buffer_load_dwordx4 v[60:63], v48, s[16:19], s33 offen offset:0 nt
  v_dot2_f32_bf16 v183, v112, v2, 0
  v_dot2_f32_bf16 v183, v113, v3, v183
  v_dot2_f32_bf16 v183, v114, v4, v183
  v_dot2_f32_bf16 v183, v115, v5, v183
  v_add_f32_dpp v30, v30, v30 quad_perm:[1,0,3,2] row_mask:0xf bank_mask:0xf
  ds_write_b32 v13, v30 offset:192
  v_max_f32 v10, v10, v30
  s_waitcnt vmcnt(18)
  buffer_load_dwordx4 v[64:67], v48, s[16:19], s33 offen offset:1024 nt
  v_dot2_f32_bf16 v24, v116, v2, 0
  v_dot2_f32_bf16 v24, v117, v3, v24
  v_dot2_f32_bf16 v24, v118, v4, v24
  v_dot2_f32_bf16 v24, v119, v5, v24
  v_add_f32_dpp v28, v180, v180 row_mirror row_mask:0xf bank_mask:0x3
  v_add_f32_dpp v29, v181, v181 row_mirror row_mask:0xf bank_mask:0x3
  v_add_f32_dpp v28, v182, v182 row_mirror row_mask:0xf bank_mask:0xc
  v_add_f32_dpp v29, v183, v183 row_mirror row_mask:0xf bank_mask:0xc
  s_waitcnt vmcnt(18)
  buffer_load_dwordx4 v[68:71], v44, s[16:19], s33 offen offset:2048 nt
  v_dot2_f32_bf16 v25, v120, v2, 0
  v_dot2_f32_bf16 v25, v121, v3, v25
  v_dot2_f32_bf16 v25, v122, v4, v25
  v_dot2_f32_bf16 v25, v123, v5, v25
  v_add_f32_dpp v30, v28, v28 row_half_mirror row_mask:0xf bank_mask:0x5
  v_add_f32_dpp v30, v29, v29 row_half_mirror row_mask:0xf bank_mask:0xa
  s_waitcnt vmcnt(18)
  buffer_load_dwordx4 v[72:75], v44, s[16:19], s33 offen offset:3072 nt
  v_dot2_f32_bf16 v26, v124, v2, 0
  v_dot2_f32_bf16 v26, v125, v3, v26
  v_dot2_f32_bf16 v26, v126, v4, v26
  v_dot2_f32_bf16 v26, v127, v5, v26
  v_add_f32_dpp v30, v30, v30 quad_perm:[2,3,0,1] row_mask:0xf bank_mask:0xf
  s_waitcnt vmcnt(18)
  buffer_load_dwordx4 v[76:79], v48, s[16:19], s33 offen offset:2048 nt
  v_dot2_f32_bf16 v27, v128, v2, 0
  v_dot2_f32_bf16 v27, v129, v3, v27
  v_dot2_f32_bf16 v27, v130, v4, v27
  v_dot2_f32_bf16 v27, v131, v5, v27
  v_add_f32_dpp v30, v30, v30 quad_perm:[1,0,3,2] row_mask:0xf bank_mask:0xf
  ds_write_b32 v13, v30 offset:256
  v_max_f32 v10, v10, v30
  s_waitcnt vmcnt(18)
  buffer_load_dwordx4 v[80:83], v48, s[16:19], s33 offen offset:3072 nt
  v_dot2_f32_bf16 v180, v132, v2, 0
  v_dot2_f32_bf16 v180, v133, v3, v180
  v_dot2_f32_bf16 v180, v134, v4, v180
  v_dot2_f32_bf16 v180, v135, v5, v180
  v_add_f32_dpp v28, v24, v24 row_mirror row_mask:0xf bank_mask:0x3
  v_add_f32_dpp v29, v25, v25 row_mirror row_mask:0xf bank_mask:0x3
  v_add_f32_dpp v28, v26, v26 row_mirror row_mask:0xf bank_mask:0xc
  v_add_f32_dpp v29, v27, v27 row_mirror row_mask:0xf bank_mask:0xc
  s_waitcnt vmcnt(18)
  buffer_load_dwordx4 v[84:87], v45, s[16:19], s33 offen offset:0 nt
  v_dot2_f32_bf16 v181, v136, v2, 0
  v_dot2_f32_bf16 v181, v137, v3, v181
  v_dot2_f32_bf16 v181, v138, v4, v181
  v_dot2_f32_bf16 v181, v139, v5, v181
  v_add_f32_dpp v30, v28, v28 row_half_mirror row_mask:0xf bank_mask:0x5
  v_add_f32_dpp v30, v29, v29 row_half_mirror row_mask:0xf bank_mask:0xa
  s_waitcnt vmcnt(18)
  buffer_load_dwordx4 v[88:91], v45, s[16:19], s33 offen offset:1024 nt
  v_dot2_f32_bf16 v182, v140, v2, 0
  v_dot2_f32_bf16 v182, v141, v3, v182
  v_dot2_f32_bf16 v182, v142, v4, v182
  v_dot2_f32_bf16 v182, v143, v5, v182
  v_add_f32_dpp v30, v30, v30 quad_perm:[2,3,0,1] row_mask:0xf bank_mask:0xf
  s_waitcnt vmcnt(18)
  buffer_load_dwordx4 v[92:95], v49, s[16:19], s33 offen offset:0 nt
  v_dot2_f32_bf16 v183, v144, v2, 0
  v_dot2_f32_bf16 v183, v145, v3, v183
  v_dot2_f32_bf16 v183, v146, v4, v183
  v_dot2_f32_bf16 v183, v147, v5, v183
  v_add_f32_dpp v30, v30, v30 quad_perm:[1,0,3,2] row_mask:0xf bank_mask:0xf
  ds_write_b32 v13, v30 offset:320
  v_max_f32 v10, v10, v30
  s_waitcnt vmcnt(18)
  buffer_load_dwordx4 v[96:99], v49, s[16:19], s33 offen offset:1024 nt
  v_dot2_f32_bf16 v24, v148, v2, 0
  v_dot2_f32_bf16 v24, v149, v3, v24
  v_dot2_f32_bf16 v24, v150, v4, v24
  v_dot2_f32_bf16 v24, v151, v5, v24
  v_add_f32_dpp v28, v180, v180 row_mirror row_mask:0xf bank_mask:0x3
  v_add_f32_dpp v29, v181, v181 row_mirror row_mask:0xf bank_mask:0x3
  v_add_f32_dpp v28, v182, v182 row_mirror row_mask:0xf bank_mask:0xc
  v_add_f32_dpp v29, v183, v183 row_mirror row_mask:0xf bank_mask:0xc
  s_waitcnt vmcnt(18)
  buffer_load_dwordx4 v[100:103], v45, s[16:19], s33 offen offset:2048 nt
  v_dot2_f32_bf16 v25, v152, v2, 0
  v_dot2_f32_bf16 v25, v153, v3, v25
  v_dot2_f32_bf16 v25, v154, v4, v25
  v_dot2_f32_bf16 v25, v155, v5, v25
  v_add_f32_dpp v30, v28, v28 row_half_mirror row_mask:0xf bank_mask:0x5
  v_add_f32_dpp v30, v29, v29 row_half_mirror row_mask:0xf bank_mask:0xa
  s_waitcnt vmcnt(18)
  buffer_load_dwordx4 v[104:107], v45, s[16:19], s33 offen offset:3072 nt
  v_dot2_f32_bf16 v26, v156, v2, 0
  v_dot2_f32_bf16 v26, v157, v3, v26
  v_dot2_f32_bf16 v26, v158, v4, v26
  v_dot2_f32_bf16 v26, v159, v5, v26
  v_add_f32_dpp v30, v30, v30 quad_perm:[2,3,0,1] row_mask:0xf bank_mask:0xf
  s_waitcnt vmcnt(18)
  buffer_load_dwordx4 v[108:111], v49, s[16:19], s33 offen offset:2048 nt
  v_dot2_f32_bf16 v27, v160, v2, 0
  v_dot2_f32_bf16 v27, v161, v3, v27
  v_dot2_f32_bf16 v27, v162, v4, v27
  v_dot2_f32_bf16 v27, v163, v5, v27
  v_add_f32_dpp v30, v30, v30 quad_perm:[1,0,3,2] row_mask:0xf bank_mask:0xf
  ds_write_b32 v13, v30 offset:384
  v_max_f32 v10, v10, v30
  s_waitcnt vmcnt(18)
  buffer_load_dwordx4 v[112:115], v49, s[16:19], s33 offen offset:3072 nt
  v_dot2_f32_bf16 v180, v164, v2, 0
  v_dot2_f32_bf16 v180, v165, v3, v180
  v_dot2_f32_bf16 v180, v166, v4, v180
  v_dot2_f32_bf16 v180, v167, v5, v180
  v_add_f32_dpp v28, v24, v24 row_mirror row_mask:0xf bank_mask:0x3
  v_add_f32_dpp v29, v25, v25 row_mirror row_mask:0xf bank_mask:0x3
  v_add_f32_dpp v28, v26, v26 row_mirror row_mask:0xf bank_mask:0xc
  v_add_f32_dpp v29, v27, v27 row_mirror row_mask:0xf bank_mask:0xc
  s_waitcnt vmcnt(18)
  buffer_load_dwordx4 v[116:119], v46, s[16:19], s33 offen offset:0 nt
  v_dot2_f32_bf16 v181, v168, v2, 0
  v_dot2_f32_bf16 v181, v169, v3, v181
  v_dot2_f32_bf16 v181, v170, v4, v181
  v_dot2_f32_bf16 v181, v171, v5, v181
  v_add_f32_dpp v30, v28, v28 row_half_mirror row_mask:0xf bank_mask:0x5
  v_add_f32_dpp v30, v29, v29 row_half_mirror row_mask:0xf bank_mask:0xa
  s_waitcnt vmcnt(18)
  buffer_load_dwordx4 v[120:123], v46, s[16:19], s33 offen offset:1024 nt
  v_dot2_f32_bf16 v182, v172, v2, 0
  v_dot2_f32_bf16 v182, v173, v3, v182
  v_dot2_f32_bf16 v182, v174, v4, v182
  v_dot2_f32_bf16 v182, v175, v5, v182
  v_add_f32_dpp v30, v30, v30 quad_perm:[2,3,0,1] row_mask:0xf bank_mask:0xf
  s_waitcnt vmcnt(18)
  buffer_load_dwordx4 v[124:127], v50, s[16:19], s33 offen offset:0 nt
  v_dot2_f32_bf16 v183, v176, v2, 0
  v_dot2_f32_bf16 v183, v177, v3, v183
  v_dot2_f32_bf16 v183, v178, v4, v183
  v_dot2_f32_bf16 v183, v179, v5, v183
  v_add_f32_dpp v30, v30, v30 quad_perm:[1,0,3,2] row_mask:0xf bank_mask:0xf
  ds_write_b32 v13, v30 offset:448
  v_max_f32 v10, v10, v30
  v_add_u32 v13, 512, v13
  s_mov_b32 s32, s33
  s_add_u32 s33, s33, 0x4000
  s_and_b32 s36, s33, 0x10000
  s_add_u32 s33, s33, s36
  s_sub_u32 s35, s35, 1
  s_cmp_eq_u32 s35, s60
  s_cbranch_scc1 L_pub
  s_cmp_eq_u32 s35, s61
  s_cbranch_scc1 L_pub2
  s_cmp_eq_u32 s35, 1
  s_cbranch_scc1 L_fetch
L_kc:
  s_cmp_lg_u32 s35, 0
  s_cbranch_scc1 L_k
  buffer_load_dwordx4 v[128:131], v50, s[16:19], s32 offen offset:1024 nt
  buffer_load_dwordx4 v[132:135], v46, s[16:19], s32 offen offset:2048 nt
  buffer_load_dwordx4 v[136:139], v46, s[16:19], s32 offen offset:3072 nt
  v_add_f32_dpp v28, v180, v180 row_mirror row_mask:0xf bank_mask:0x3
  v_add_f32_dpp v29, v181, v181 row_mirror row_mask:0xf bank_mask:0x3
  v_add_f32_dpp v28, v182, v182 row_mirror row_mask:0xf bank_mask:0xc
  v_add_f32_dpp v29, v183, v183 row_mirror row_mask:0xf bank_mask:0xc
  s_nop 1
  v_add_f32_dpp v30, v28, v28 row_half_mirror row_mask:0xf bank_mask:0x5
  v_add_f32_dpp v30, v29, v29 row_half_mirror row_mask:0xf bank_mask:0xa
  s_nop 1
  v_add_f32_dpp v30, v30, v30 quad_perm:[2,3,0,1] row_mask:0xf bank_mask:0xf
  s_nop 1
  s_nop 1
  v_add_f32_dpp v30, v30, v30 quad_perm:[1,0,3,2] row_mask:0xf bank_mask:0xf
  ds_write_b32 v13, v30 offset:0
  v_max_f32 v10, v10, v30
  s_nop 1
  s_memrealtime s[64:65]
  v_mov_b32 v33, 0xff800000
  ds_write_b32 v13, v33 offset:64
  v_and_b32 v13, 0x3c, v0
  v_add_u32 v13, 64, v13
  v_max_f32_dpp v33, v10, v10 row_half_mirror row_mask:0xf bank_mask:0xf
  s_waitcnt lgkmcnt(0)
  ds_read_b32 v14, v13
  v_max_f32_dpp v33, v33, v33 row_mirror row_mask:0xf bank_mask:0xf
  s_nop 1
  v_readlane_b32 s40, v33, 0
  v_readlane_b32 s41, v33, 16
  v_readlane_b32 s42, v33, 32
  v_readlane_b32 s43, v33, 48
  s_mov_b32 s35, 64
  s_nop 0
  v_mov_b32 v33, s40
  v_max_f32 v33, s41, v33
  v_max_f32 v33, s42, v33
  v_max_f32 v33, s43, v33
  v_mul_f32 v11, s34, v33
  v_cmp_eq_u32 vcc, 0, v35
  v_subrev_u32 v35, s64, v35
  s_nop 1
  v_add_u32_dpp v35, v35, v35 row_ror:2 row_mask:0xf bank_mask:0xf
  s_nop 1
  v_add_u32_dpp v35, v35, v35 row_ror:4 row_mask:0xf bank_mask:0xf
  s_nop 1
  v_add_u32_dpp v35, v35, v35 row_ror:8 row_mask:0xf bank_mask:0xf
  s_nop 1
  v_readlane_b32 s40, v35, 0
  v_readlane_b32 s72, v35, 1
  v_readlane_b32 s41, v35, 16
  v_readlane_b32 s73, v35, 17
  v_readlane_b32 s42, v35, 32
  v_readlane_b32 s74, v35, 33
  v_readlane_b32 s43, v35, 48
  v_readlane_b32 s75, v35, 49
  s_nop 3
  s_add_i32 s40, s40, s41
  s_add_i32 s72, s72, s73
  s_add_i32 s40, s40, s42
  s_add_i32 s72, s72, s74
  s_add_i32 s40, s40, s43
  s_add_i32 s72, s72, s75
  s_sub_i32 s40, s72, s40
  s_mul_i32 s40, s40, 819
  s_ashr_i32 s40, s40, 16
  s_ashr_i32 s72, s72, 1
  s_mov_b32 s78, s72
  s_mul_i32 s41, s40, 12
  s_add_i32 s72, s72, s41
  s_add_i32 s72, s72, 1360
  s_cmp_lg_u64 vcc, 0
  s_cselect_b32 s70, 0x3fffffff, s72
  s_cselect_b32 s66, 0, s40
  s_cmp_lt_u32 s2, 32
  s_cselect_b32 s60, 58, -1
  s_mov_b32 s61, 49
  s_mov_b32 s79, 3641
  s_mov_b32 s77, 0
  s_waitcnt lgkmcnt(0)
  v_fma_f32 v31, v14, s34, -v11
  ds_read_b32 v15, v13 offset:64
  v_exp_f32 v31, v31
  s_nop 1
  v_cvt_pk_bf16_f32 v32, v31, v31
  v_add_f32 v12, v12, v31
  v_and_b32 v36, v32, v6
  v_and_b32 v37, v32, v7
  s_nop 1
  v_and_b32_dpp v38, v32, v8 row_half_mirror row_mask:0xf bank_mask:0xf
  v_and_b32_dpp v39, v32, v9 row_half_mirror row_mask:0xf bank_mask:0xf
  v_and_b32 v42, v32, v8
  s_nop 1
  v_and_b32 v43, v32, v9
  v_and_b32_dpp v40, v32, v6 row_half_mirror row_mask:0xf bank_mask:0xf
  v_and_b32_dpp v41, v32, v7 row_half_mirror row_mask:0xf bank_mask:0xf
  s_nop 1
  s_cmp_lt_i32 s70, 0
  s_cbranch_scc0 L_vs
L_vf:
  s_memrealtime s[68:69]
  s_waitcnt vmcnt(21)
  buffer_load_dwordx4 v[140:143], v50, s[16:19], s32 offen offset:2048 nt
  v_mfma_f32_16x16x32_bf16 v[16:19], v[36:39], v[52:55], v[16:19]
  s_waitcnt lgkmcnt(0)
  v_fma_f32 v31, v15, s34, -v11
  ds_read_b32 v14, v13 offset:128
  v_exp_f32 v31, v31
  s_waitcnt vmcnt(21)
  buffer_load_dwordx4 v[144:147], v50, s[16:19], s32 offen offset:3072 nt
  v_mfma_f32_16x16x32_bf16 v[16:19], v[40:43], v[56:59], v[16:19]
  v_cvt_pk_bf16_f32 v32, v31, v31
  v_add_f32 v12, v12, v31
  v_and_b32 v184, v32, v6
  v_and_b32 v185, v32, v7
  s_waitcnt vmcnt(21)
  buffer_load_dwordx4 v[148:151], v47, s[16:19], s32 offen offset:0 nt
  v_mfma_f32_16x16x32_bf16 v[20:23], v[36:39], v[60:63], v[20:23]
  v_and_b32_dpp v186, v32, v8 row_half_mirror row_mask:0xf bank_mask:0xf
  v_and_b32_dpp v187, v32, v9 row_half_mirror row_mask:0xf bank_mask:0xf
  v_and_b32 v190, v32, v8
  s_waitcnt vmcnt(21)
  buffer_load_dwordx4 v[152:155], v47, s[16:19], s32 offen offset:1024 nt
  v_mfma_f32_16x16x32_bf16 v[20:23], v[40:43], v[64:67], v[20:23]
  v_and_b32 v191, v32, v9
  v_and_b32_dpp v188, v32, v6 row_half_mirror row_mask:0xf bank_mask:0xf
  v_and_b32_dpp v189, v32, v7 row_half_mirror row_mask:0xf bank_mask:0xf
  s_waitcnt vmcnt(21)
  buffer_load_dwordx4 v[156:159], v51, s[16:19], s32 offen offset:0 nt
  v_mfma_f32_16x16x32_bf16 v[16:19], v[184:187], v[68:71], v[16:19]
  s_waitcnt lgkmcnt(0)
  v_fma_f32 v31, v14, s34, -v11
  ds_read_b32 v15, v13 offset:192
  v_exp_f32 v31, v31
  s_waitcnt vmcnt(21)
  buffer_load_dwordx4 v[160:163], v51, s[16:19], s32 offen offset:1024 nt
  v_mfma_f32_16x16x32_bf16 v[16:19], v[188:191], v[72:75], v[16:19]
  v_cvt_pk_bf16_f32 v32, v31, v31
  v_add_f32 v12, v12, v31
  v_and_b32 v36, v32, v6
  v_and_b32 v37, v32, v7
  s_waitcnt vmcnt(21)
  buffer_load_dwordx4 v[164:167], v47, s[16:19], s32 offen offset:2048 nt
  v_mfma_f32_16x16x32_bf16 v[20:23], v[184:187], v[76:79], v[20:23]
  v_and_b32_dpp v38, v32, v8 row_half_mirror row_mask:0xf bank_mask:0xf
  v_and_b32_dpp v39, v32, v9 row_half_mirror row_mask:0xf bank_mask:0xf
  v_and_b32 v42, v32, v8
  s_waitcnt vmcnt(21)
  buffer_load_dwordx4 v[168:171], v47, s[16:19], s32 offen offset:3072 nt
  v_mfma_f32_16x16x32_bf16 v[20:23], v[188:191], v[80:83], v[20:23]
  v_and_b32 v43, v32, v9
  v_and_b32_dpp v40, v32, v6 row_half_mirror row_mask:0xf bank_mask:0xf
  v_and_b32_dpp v41, v32, v7 row_half_mirror row_mask:0xf bank_mask:0xf
  s_waitcnt vmcnt(21)
  buffer_load_dwordx4 v[172:175], v51, s[16:19], s32 offen offset:2048 nt
  v_mfma_f32_16x16x32_bf16 v[16:19], v[36:39], v[84:87], v[16:19]
  s_waitcnt lgkmcnt(0)
  v_fma_f32 v31, v15, s34, -v11
  ds_read_b32 v14, v13 offset:256
  v_exp_f32 v31, v31
  s_waitcnt vmcnt(21)
  buffer_load_dwordx4 v[176:179], v51, s[16:19], s32 offen offset:3072 nt
  v_mfma_f32_16x16x32_bf16 v[16:19], v[40:43], v[88:91], v[16:19]
  v_cvt_pk_bf16_f32 v32, v31, v31
  v_add_f32 v12, v12, v31
  v_and_b32 v184, v32, v6
  v_and_b32 v185, v32, v7
  s_waitcnt vmcnt(21)
  buffer_load_dwordx4 v[52:55], v44, s[16:19], s33 offen offset:0 nt
  v_mfma_f32_16x16x32_bf16 v[20:23], v[36:39], v[92:95], v[20:23]
  v_and_b32_dpp v186, v32, v8 row_half_mirror row_mask:0xf bank_mask:0xf
  v_and_b32_dpp v187, v32, v9 row_half_mirror row_mask:0xf bank_mask:0xf
  v_and_b32 v190, v32, v8
  s_waitcnt vmcnt(21)
  buffer_load_dwordx4 v[56:59], v44, s[16:19], s33 offen offset:1024 nt
  v_mfma_f32_16x16x32_bf16 v[20:23], v[40:43], v[96:99], v[20:23]
  v_and_b32 v191, v32, v9
  v_and_b32_dpp v188, v32, v6 row_half_mirror row_mask:0xf bank_mask:0xf
  v_and_b32_dpp v189, v32, v7 row_half_mirror row_mask:0xf bank_mask:0xf
  s_waitcnt vmcnt(21)
  buffer_load_dwordx4 v[60:63], v48, s[16:19], s33 offen offset:0 nt
  v_mfma_f32_16x16x32_bf16 v[16:19], v[184:187], v[100:103], v[16:19]
  s_waitcnt lgkmcnt(0)
  v_fma_f32 v31, v14, s34, -v11
  ds_read_b32 v15, v13 offset:320
  v_exp_f32 v31, v31
  s_waitcnt vmcnt(21)
  buffer_load_dwordx4 v[64:67], v48, s[16:19], s33 offen offset:1024 nt
  v_mfma_f32_16x16x32_bf16 v[16:19], v[188:191], v[104:107], v[16:19]
  v_cvt_pk_bf16_f32 v32, v31, v31
  v_add_f32 v12, v12, v31
  v_and_b32 v36, v32, v6
  v_and_b32 v37, v32, v7
  s_waitcnt vmcnt(21)
  buffer_load_dwordx4 v[68:71], v44, s[16:19], s33 offen offset:2048 nt
  v_mfma_f32_16x16x32_bf16 v[20:23], v[184:187], v[108:111], v[20:23]
  v_and_b32_dpp v38, v32, v8 row_half_mirror row_mask:0xf bank_mask:0xf
  v_and_b32_dpp v39, v32, v9 row_half_mirror row_mask:0xf bank_mask:0xf
  v_and_b32 v42, v32, v8
  s_waitcnt vmcnt(21)
  buffer_load_dwordx4 v[72:75], v44, s[16:19], s33 offen offset:3072 nt
  v_mfma_f32_16x16x32_bf16 v[20:23], v[188:191], v[112:115], v[20:23]
  v_and_b32 v43, v32, v9
  v_and_b32_dpp v40, v32, v6 row_half_mirror row_mask:0xf bank_mask:0xf
  v_and_b32_dpp v41, v32, v7 row_half_mirror row_mask:0xf bank_mask:0xf
  s_waitcnt vmcnt(21)
  buffer_load_dwordx4 v[76:79], v48, s[16:19], s33 offen offset:2048 nt
  v_mfma_f32_16x16x32_bf16 v[16:19], v[36:39], v[116:119], v[16:19]
  s_waitcnt lgkmcnt(0)
  v_fma_f32 v31, v15, s34, -v11
  ds_read_b32 v14, v13 offset:384
  v_exp_f32 v31, v31
  s_waitcnt vmcnt(21)
  buffer_load_dwordx4 v[80:83], v48, s[16:19], s33 offen offset:3072 nt
  v_mfma_f32_16x16x32_bf16 v[16:19], v[40:43], v[120:123], v[16:19]
  v_cvt_pk_bf16_f32 v32, v31, v31
  v_add_f32 v12, v12, v31
  v_and_b32 v184, v32, v6
  v_and_b32 v185, v32, v7
  s_waitcnt vmcnt(21)
  buffer_load_dwordx4 v[84:87], v45, s[16:19], s33 offen offset:0 nt
  v_mfma_f32_16x16x32_bf16 v[20:23], v[36:39], v[124:127], v[20:23]
  v_and_b32_dpp v186, v32, v8 row_half_mirror row_mask:0xf bank_mask:0xf
  v_and_b32_dpp v187, v32, v9 row_half_mirror row_mask:0xf bank_mask:0xf
  v_and_b32 v190, v32, v8
  s_waitcnt vmcnt(21)
  buffer_load_dwordx4 v[88:91], v45, s[16:19], s33 offen offset:1024 nt
  v_mfma_f32_16x16x32_bf16 v[20:23], v[40:43], v[128:131], v[20:23]
  v_and_b32 v191, v32, v9
  v_and_b32_dpp v188, v32, v6 row_half_mirror row_mask:0xf bank_mask:0xf
  v_and_b32_dpp v189, v32, v7 row_half_mirror row_mask:0xf bank_mask:0xf
  s_waitcnt vmcnt(21)
  buffer_load_dwordx4 v[92:95], v49, s[16:19], s33 offen offset:0 nt
  v_mfma_f32_16x16x32_bf16 v[16:19], v[184:187], v[132:135], v[16:19]
  s_waitcnt lgkmcnt(0)
  v_fma_f32 v31, v14, s34, -v11
  ds_read_b32 v15, v13 offset:448
  v_exp_f32 v31, v31
  s_waitcnt vmcnt(21)
  buffer_load_dwordx4 v[96:99], v49, s[16:19], s33 offen offset:1024 nt
  v_mfma_f32_16x16x32_bf16 v[16:19], v[188:191], v[136:139], v[16:19]
  v_cvt_pk_bf16_f32 v32, v31, v31
  v_add_f32 v12, v12, v31
  v_and_b32 v36, v32, v6
  v_and_b32 v37, v32, v7
  s_waitcnt vmcnt(21)
  buffer_load_dwordx4 v[100:103], v45, s[16:19], s33 offen offset:2048 nt
  v_mfma_f32_16x16x32_bf16 v[20:23], v[184:187], v[140:143], v[20:23]
  v_and_b32_dpp v38, v32, v8 row_half_mirror row_mask:0xf bank_mask:0xf
  v_and_b32_dpp v39, v32, v9 row_half_mirror row_mask:0xf bank_mask:0xf
  v_and_b32 v42, v32, v8
  s_waitcnt vmcnt(21)
  buffer_load_dwordx4 v[104:107], v45, s[16:19], s33 offen offset:3072 nt
  v_mfma_f32_16x16x32_bf16 v[20:23], v[188:191], v[144:147], v[20:23]
  v_and_b32 v43, v32, v9
  v_and_b32_dpp v40, v32, v6 row_half_mirror row_mask:0xf bank_mask:0xf
  v_and_b32_dpp v41, v32, v7 row_half_mirror row_mask:0xf bank_mask:0xf
  s_waitcnt vmcnt(21)
  buffer_load_dwordx4 v[108:111], v49, s[16:19], s33 offen offset:2048 nt
  v_mfma_f32_16x16x32_bf16 v[16:19], v[36:39], v[148:151], v[16:19]
  s_waitcnt lgkmcnt(0)
  v_fma_f32 v31, v15, s34, -v11
  ds_read_b32 v14, v13 offset:512
  v_exp_f32 v31, v31
  s_waitcnt vmcnt(21)
  buffer_load_dwordx4 v[112:115], v49, s[16:19], s33 offen offset:3072 nt
  v_mfma_f32_16x16x32_bf16 v[16:19], v[40:43], v[152:155], v[16:19]
  v_cvt_pk_bf16_f32 v32, v31, v31
  v_add_f32 v12, v12, v31
  v_and_b32 v184, v32, v6
  v_and_b32 v185, v32, v7
  s_waitcnt vmcnt(21)
  buffer_load_dwordx4 v[116:119], v46, s[16:19], s33 offen offset:0 nt
  v_mfma_f32_16x16x32_bf16 v[20:23], v[36:39], v[156:159], v[20:23]
  v_and_b32_dpp v186, v32, v8 row_half_mirror row_mask:0xf bank_mask:0xf
  v_and_b32_dpp v187, v32, v9 row_half_mirror row_mask:0xf bank_mask:0xf
  v_and_b32 v190, v32, v8
  s_waitcnt vmcnt(21)
  buffer_load_dwordx4 v[120:123], v46, s[16:19], s33 offen offset:1024 nt
  v_mfma_f32_16x16x32_bf16 v[20:23], v[40:43], v[160:163], v[20:23]
  v_and_b32 v191, v32, v9
  v_and_b32_dpp v188, v32, v6 row_half_mirror row_mask:0xf bank_mask:0xf
  v_and_b32_dpp v189, v32, v7 row_half_mirror row_mask:0xf bank_mask:0xf
  s_waitcnt vmcnt(21)
  buffer_load_dwordx4 v[124:127], v50, s[16:19], s33 offen offset:0 nt
  v_mfma_f32_16x16x32_bf16 v[16:19], v[184:187], v[164:167], v[16:19]
  s_waitcnt lgkmcnt(0)
  v_fma_f32 v31, v14, s34, -v11
  ds_read_b32 v15, v13 offset:576
  v_exp_f32 v31, v31
  s_waitcnt vmcnt(21)
  buffer_load_dwordx4 v[128:131], v50, s[16:19], s33 offen offset:1024 nt
  v_mfma_f32_16x16x32_bf16 v[16:19], v[188:191], v[168:171], v[16:19]
  v_cvt_pk_bf16_f32 v32, v31, v31
  v_add_f32 v12, v12, v31
  v_and_b32 v36, v32, v6
  v_and_b32 v37, v32, v7
  s_waitcnt vmcnt(21)
  buffer_load_dwordx4 v[132:135], v46, s[16:19], s33 offen offset:2048 nt
  v_mfma_f32_16x16x32_bf16 v[20:23], v[184:187], v[172:175], v[20:23]
  v_and_b32_dpp v38, v32, v8 row_half_mirror row_mask:0xf bank_mask:0xf
  v_and_b32_dpp v39, v32, v9 row_half_mirror row_mask:0xf bank_mask:0xf
  v_and_b32 v42, v32, v8
  s_waitcnt vmcnt(21)
  buffer_load_dwordx4 v[136:139], v46, s[16:19], s33 offen offset:3072 nt
  v_mfma_f32_16x16x32_bf16 v[20:23], v[188:191], v[176:179], v[20:23]
  v_and_b32 v43, v32, v9
  v_and_b32_dpp v40, v32, v6 row_half_mirror row_mask:0xf bank_mask:0xf
  v_and_b32_dpp v41, v32, v7 row_half_mirror row_mask:0xf bank_mask:0xf
  v_add_u32 v13, 512, v13
  s_mov_b32 s32, s33
  s_add_u32 s33, s33, 0x4000
  s_and_b32 s36, s33, 0x10000
  s_add_u32 s33, s33, s36
  s_sub_u32 s35, s35, 1
  s_branch L_vc
L_vs:
  s_memrealtime s[68:69]
  s_waitcnt vmcnt(17)
  buffer_load_dwordx4 v[140:143], v50, s[16:19], s32 offen offset:2048 nt
  v_mfma_f32_16x16x32_bf16 v[16:19], v[36:39], v[52:55], v[16:19]
  s_waitcnt lgkmcnt(0)
  v_fma_f32 v31, v15, s34, -v11
  ds_read_b32 v14, v13 offset:128
  v_exp_f32 v31, v31
  s_waitcnt vmcnt(18)
  buffer_load_dwordx4 v[144:147], v50, s[16:19], s32 offen offset:3072 nt
  v_mfma_f32_16x16x32_bf16 v[16:19], v[40:43], v[56:59], v[16:19]
  v_cvt_pk_bf16_f32 v32, v31, v31
  v_add_f32 v12, v12, v31
  v_and_b32 v184, v32, v6
  v_and_b32 v185, v32, v7
  s_waitcnt vmcnt(17)
  buffer_load_dwordx4 v[148:151], v47, s[16:19], s32 offen offset:0 nt
  v_mfma_f32_16x16x32_bf16 v[20:23], v[36:39], v[60:63], v[20:23]
  v_and_b32_dpp v186, v32, v8 row_half_mirror row_mask:0xf bank_mask:0xf
  v_and_b32_dpp v187, v32, v9 row_half_mirror row_mask:0xf bank_mask:0xf
  v_and_b32 v190, v32, v8
  s_waitcnt vmcnt(18)
  buffer_load_dwordx4 v[152:155], v47, s[16:19], s32 offen offset:1024 nt
  v_mfma_f32_16x16x32_bf16 v[20:23], v[40:43], v[64:67], v[20:23]
  v_and_b32 v191, v32, v9
  v_and_b32_dpp v188, v32, v6 row_half_mirror row_mask:0xf bank_mask:0xf
  v_and_b32_dpp v189, v32, v7 row_half_mirror row_mask:0xf bank_mask:0xf
  s_waitcnt vmcnt(17)
  buffer_load_dwordx4 v[156:159], v51, s[16:19], s32 offen offset:0 nt
  v_mfma_f32_16x16x32_bf16 v[16:19], v[184:187], v[68:71], v[16:19]
  s_waitcnt lgkmcnt(0)
  v_fma_f32 v31, v14, s34, -v11
  ds_read_b32 v15, v13 offset:192
  v_exp_f32 v31, v31
  s_waitcnt vmcnt(18)
  buffer_load_dwordx4 v[160:163], v51, s[16:19], s32 offen offset:1024 nt
  v_mfma_f32_16x16x32_bf16 v[16:19], v[188:191], v[72:75], v[16:19]
  v_cvt_pk_bf16_f32 v32, v31, v31
  v_add_f32 v12, v12, v31
  v_and_b32 v36, v32, v6
  v_and_b32 v37, v32, v7
  s_waitcnt vmcnt(17)
  buffer_load_dwordx4 v[164:167], v47, s[16:19], s32 offen offset:2048 nt
  v_mfma_f32_16x16x32_bf16 v[20:23], v[184:187], v[76:79], v[20:23]
  v_and_b32_dpp v38, v32, v8 row_half_mirror row_mask:0xf bank_mask:0xf
  v_and_b32_dpp v39, v32, v9 row_half_mirror row_mask:0xf bank_mask:0xf
  v_and_b32 v42, v32, v8
  s_waitcnt vmcnt(18)
  buffer_load_dwordx4 v[168:171], v47, s[16:19], s32 offen offset:3072 nt
  v_mfma_f32_16x16x32_bf16 v[20:23], v[188:191], v[80:83], v[20:23]
  v_and_b32 v43, v32, v9
  v_and_b32_dpp v40, v32, v6 row_half_mirror row_mask:0xf bank_mask:0xf
  v_and_b32_dpp v41, v32, v7 row_half_mirror row_mask:0xf bank_mask:0xf
  s_waitcnt vmcnt(17)
  buffer_load_dwordx4 v[172:175], v51, s[16:19], s32 offen offset:2048 nt
  v_mfma_f32_16x16x32_bf16 v[16:19], v[36:39], v[84:87], v[16:19]
  s_waitcnt lgkmcnt(0)
  v_fma_f32 v31, v15, s34, -v11
  ds_read_b32 v14, v13 offset:256
  v_exp_f32 v31, v31
  s_waitcnt vmcnt(18)
  buffer_load_dwordx4 v[176:179], v51, s[16:19], s32 offen offset:3072 nt
  v_mfma_f32_16x16x32_bf16 v[16:19], v[40:43], v[88:91], v[16:19]
  v_cvt_pk_bf16_f32 v32, v31, v31
  v_add_f32 v12, v12, v31
  v_and_b32 v184, v32, v6
  v_and_b32 v185, v32, v7
  s_waitcnt vmcnt(17)
  buffer_load_dwordx4 v[52:55], v44, s[16:19], s33 offen offset:0 nt
  v_mfma_f32_16x16x32_bf16 v[20:23], v[36:39], v[92:95], v[20:23]
  v_and_b32_dpp v186, v32, v8 row_half_mirror row_mask:0xf bank_mask:0xf
  v_and_b32_dpp v187, v32, v9 row_half_mirror row_mask:0xf bank_mask:0xf
  v_and_b32 v190, v32, v8
  s_waitcnt vmcnt(18)
  buffer_load_dwordx4 v[56:59], v44, s[16:19], s33 offen offset:1024 nt
  v_mfma_f32_16x16x32_bf16 v[20:23], v[40:43], v[96:99], v[20:23]
  v_and_b32 v191, v32, v9
  v_and_b32_dpp v188, v32, v6 row_half_mirror row_mask:0xf bank_mask:0xf
  v_and_b32_dpp v189, v32, v7 row_half_mirror row_mask:0xf bank_mask:0xf
  s_waitcnt vmcnt(17)
  buffer_load_dwordx4 v[60:63], v48, s[16:19], s33 offen offset:0 nt
  v_mfma_f32_16x16x32_bf16 v[16:19], v[184:187], v[100:103], v[16:19]
  s_waitcnt lgkmcnt(0)
  v_fma_f32 v31, v14, s34, -v11
  ds_read_b32 v15, v13 offset:320
  v_exp_f32 v31, v31
  s_waitcnt vmcnt(18)
  buffer_load_dwordx4 v[64:67], v48, s[16:19], s33 offen offset:1024 nt
  v_mfma_f32_16x16x32_bf16 v[16:19], v[188:191], v[104:107], v[16:19]
  v_cvt_pk_bf16_f32 v32, v31, v31
  v_add_f32 v12, v12, v31
  v_and_b32 v36, v32, v6
  v_and_b32 v37, v32, v7
  s_waitcnt vmcnt(17)
  buffer_load_dwordx4 v[68:71], v44, s[16:19], s33 offen offset:2048 nt
  v_mfma_f32_16x16x32_bf16 v[20:23], v[184:187], v[108:111], v[20:23]
  v_and_b32_dpp v38, v32, v8 row_half_mirror row_mask:0xf bank_mask:0xf
  v_and_b32_dpp v39, v32, v9 row_half_mirror row_mask:0xf bank_mask:0xf
  v_and_b32 v42, v32, v8
  s_waitcnt vmcnt(18)
  buffer_load_dwordx4 v[72:75], v44, s[16:19], s33 offen offset:3072 nt
  v_mfma_f32_16x16x32_bf16 v[20:23], v[188:191], v[112:115], v[20:23]
  v_and_b32 v43, v32, v9
  v_and_b32_dpp v40, v32, v6 row_half_mirror row_mask:0xf bank_mask:0xf
  v_and_b32_dpp v41, v32, v7 row_half_mirror row_mask:0xf bank_mask:0xf
  s_waitcnt vmcnt(17)
  buffer_load_dwordx4 v[76:79], v48, s[16:19], s33 offen offset:2048 nt
  v_mfma_f32_16x16x32_bf16 v[16:19], v[36:39], v[116:119], v[16:19]
  s_waitcnt lgkmcnt(0)
  v_fma_f32 v31, v15, s34, -v11
  ds_read_b32 v14, v13 offset:384
  v_exp_f32 v31, v31
  s_waitcnt vmcnt(18)
  buffer_load_dwordx4 v[80:83], v48, s[16:19], s33 offen offset:3072 nt
  v_mfma_f32_16x16x32_bf16 v[16:19], v[40:43], v[120:123], v[16:19]
  v_cvt_pk_bf16_f32 v32, v31, v31
  v_add_f32 v12, v12, v31
  v_and_b32 v184, v32, v6
  v_and_b32 v185, v32, v7
  s_waitcnt vmcnt(17)
  buffer_load_dwordx4 v[84:87], v45, s[16:19], s33 offen offset:0 nt
  v_mfma_f32_16x16x32_bf16 v[20:23], v[36:39], v[124:127], v[20:23]
  v_and_b32_dpp v186, v32, v8 row_half_mirror row_mask:0xf bank_mask:0xf
  v_and_b32_dpp v187, v32, v9 row_half_mirror row_mask:0xf bank_mask:0xf
  v_and_b32 v190, v32, v8
  s_waitcnt vmcnt(18)
  buffer_load_dwordx4 v[88:91], v45, s[16:19], s33 offen offset:1024 nt
  v_mfma_f32_16x16x32_bf16 v[20:23], v[40:43], v[128:131], v[20:23]
  v_and_b32 v191, v32, v9
  v_and_b32_dpp v188, v32, v6 row_half_mirror row_mask:0xf bank_mask:0xf
  v_and_b32_dpp v189, v32, v7 row_half_mirror row_mask:0xf bank_mask:0xf
  s_waitcnt vmcnt(17)
  buffer_load_dwordx4 v[92:95], v49, s[16:19], s33 offen offset:0 nt
  v_mfma_f32_16x16x32_bf16 v[16:19], v[184:187], v[132:135], v[16:19]
  s_waitcnt lgkmcnt(0)
  v_fma_f32 v31, v14, s34, -v11
  ds_read_b32 v15, v13 offset:448
  v_exp_f32 v31, v31
  s_waitcnt vmcnt(18)
  buffer_load_dwordx4 v[96:99], v49, s[16:19], s33 offen offset:1024 nt
  v_mfma_f32_16x16x32_bf16 v[16:19], v[188:191], v[136:139], v[16:19]
  v_cvt_pk_bf16_f32 v32, v31, v31
  v_add_f32 v12, v12, v31
  v_and_b32 v36, v32, v6
  v_and_b32 v37, v32, v7
  s_waitcnt vmcnt(17)
  buffer_load_dwordx4 v[100:103], v45, s[16:19], s33 offen offset:2048 nt
  v_mfma_f32_16x16x32_bf16 v[20:23], v[184:187], v[140:143], v[20:23]
  v_and_b32_dpp v38, v32, v8 row_half_mirror row_mask:0xf bank_mask:0xf
  v_and_b32_dpp v39, v32, v9 row_half_mirror row_mask:0xf bank_mask:0xf
  v_and_b32 v42, v32, v8
  s_waitcnt vmcnt(18)
  buffer_load_dwordx4 v[104:107], v45, s[16:19], s33 offen offset:3072 nt
  v_mfma_f32_16x16x32_bf16 v[20:23], v[188:191], v[144:147], v[20:23]
  v_and_b32 v43, v32, v9
  v_and_b32_dpp v40, v32, v6 row_half_mirror row_mask:0xf bank_mask:0xf
  v_and_b32_dpp v41, v32, v7 row_half_mirror row_mask:0xf bank_mask:0xf
  s_waitcnt vmcnt(17)
  buffer_load_dwordx4 v[108:111], v49, s[16:19], s33 offen offset:2048 nt
  v_mfma_f32_16x16x32_bf16 v[16:19], v[36:39], v[148:151], v[16:19]
  s_waitcnt lgkmcnt(0)
  v_fma_f32 v31, v15, s34, -v11
  ds_read_b32 v14, v13 offset:512
  v_exp_f32 v31, v31
  s_waitcnt vmcnt(18)
  buffer_load_dwordx4 v[112:115], v49, s[16:19], s33 offen offset:3072 nt
  v_mfma_f32_16x16x32_bf16 v[16:19], v[40:43], v[152:155], v[16:19]
  v_cvt_pk_bf16_f32 v32, v31, v31
  v_add_f32 v12, v12, v31
  v_and_b32 v184, v32, v6
  v_and_b32 v185, v32, v7
  s_waitcnt vmcnt(17)
  buffer_load_dwordx4 v[116:119], v46, s[16:19], s33 offen offset:0 nt
  v_mfma_f32_16x16x32_bf16 v[20:23], v[36:39], v[156:159], v[20:23]
  v_and_b32_dpp v186, v32, v8 row_half_mirror row_mask:0xf bank_mask:0xf
  v_and_b32_dpp v187, v32, v9 row_half_mirror row_mask:0xf bank_mask:0xf
  v_and_b32 v190, v32, v8
  s_waitcnt vmcnt(18)
  buffer_load_dwordx4 v[120:123], v46, s[16:19], s33 offen offset:1024 nt
  v_mfma_f32_16x16x32_bf16 v[20:23], v[40:43], v[160:163], v[20:23]
  v_and_b32 v191, v32, v9
  v_and_b32_dpp v188, v32, v6 row_half_mirror row_mask:0xf bank_mask:0xf
  v_and_b32_dpp v189, v32, v7 row_half_mirror row_mask:0xf bank_mask:0xf
  s_waitcnt vmcnt(17)
  buffer_load_dwordx4 v[124:127], v50, s[16:19], s33 offen offset:0 nt
  v_mfma_f32_16x16x32_bf16 v[16:19], v[184:187], v[164:167], v[16:19]
  s_waitcnt lgkmcnt(0)
  v_fma_f32 v31, v14, s34, -v11
  ds_read_b32 v15, v13 offset:576
  v_exp_f32 v31, v31
  s_waitcnt vmcnt(18)
  buffer_load_dwordx4 v[128:131], v50, s[16:19], s33 offen offset:1024 nt
  v_mfma_f32_16x16x32_bf16 v[16:19], v[188:191], v[168:171], v[16:19]
  v_cvt_pk_bf16_f32 v32, v31, v31
  v_add_f32 v12, v12, v31
  v_and_b32 v36, v32, v6
  v_and_b32 v37, v32, v7
  s_waitcnt vmcnt(17)
  buffer_load_dwordx4 v[132:135], v46, s[16:19], s33 offen offset:2048 nt
  v_mfma_f32_16x16x32_bf16 v[20:23], v[184:187], v[172:175], v[20:23]
  v_and_b32_dpp v38, v32, v8 row_half_mirror row_mask:0xf bank_mask:0xf
  v_and_b32_dpp v39, v32, v9 row_half_mirror row_mask:0xf bank_mask:0xf
  v_and_b32 v42, v32, v8
  s_waitcnt vmcnt(18)
  buffer_load_dwordx4 v[136:139], v46, s[16:19], s33 offen offset:3072 nt
  v_mfma_f32_16x16x32_bf16 v[20:23], v[188:191], v[176:179], v[20:23]
  v_and_b32 v43, v32, v9
  v_and_b32_dpp v40, v32, v6 row_half_mirror row_mask:0xf bank_mask:0xf
  v_and_b32_dpp v41, v32, v7 row_half_mirror row_mask:0xf bank_mask:0xf
  v_add_u32 v13, 512, v13
  s_mov_b32 s32, s33
  s_add_u32 s33, s33, 0x4000
  s_and_b32 s36, s33, 0x10000
  s_add_u32 s33, s33, s36
  s_sub_u32 s35, s35, 1
L_vc:
  s_cmp_eq_u32 s35, 0
  s_cbranch_scc1 L_fin
  s_cmp_eq_u32 s35, s60
  s_cbranch_scc1 L_pub3
  s_cmp_eq_u32 s35, s61
  s_cbranch_scc1 L_fetch2
  s_add_u32 s67, s35, 1
  s_cmp_eq_u32 s67, s61
  s_cbranch_scc1 L_anchor
L_vd:
  s_sub_u32 s67, s68, s64
  s_lshl_b32 s67, s67, 4
  s_cmp_gt_i32 s67, s70
  s_cselect_b32 s71, 1, 0
  s_add_i32 s70, s70, s66
  s_cmp_lg_u32 s71, 0
  s_cbranch_scc1 L_vf
  s_branch L_vs
L_fin:
  s_nop 4
  v_add_f32_dpp v33, v12, v12 row_half_mirror row_mask:0xf bank_mask:0xf
  s_nop 1
  v_add_f32_dpp v33, v33, v33 row_mirror row_mask:0xf bank_mask:0xf
  s_nop 1
  v_readlane_b32 s40, v33, 0
  v_readlane_b32 s41, v33, 16
  v_readlane_b32 s42, v33, 32
  v_readlane_b32 s43, v33, 48
  s_nop 1
  v_mov_b32 v11, s40
  v_add_f32 v11, s41, v11
  v_add_f32 v11, s42, v11
  v_add_f32 v11, s43, v11
  v_rcp_f32 v11, v11
  v_permlane32_swap_b32 v20, v36
  v_permlane32_swap_b32 v21, v37
  v_permlane32_swap_b32 v22, v38
  v_permlane32_swap_b32 v23, v39
  v_and_b32 v28, 15, v0
  v_lshlrev_b32 v28, 4, v28
  v_bfe_u32 v29, v0, 4, 1
  v_lshl_add_u32 v28, v29, 3, v28
  v_lshrrev_b32 v29, 5, v0
  v_lshl_add_u32 v28, v29, 30, v28
  v_add_f32 v36, v36, v16
  v_add_f32 v37, v37, v17
  v_add_f32 v38, v38, v18
  v_add_f32 v39, v39, v19
  v_mul_f32 v36, v36, v11
  v_mul_f32 v37, v37, v11
  v_mul_f32 v38, v38, v11
  v_mul_f32 v39, v39, v11
  v_cvt_pk_bf16_f32 v40, v36, v37
  v_cvt_pk_bf16_f32 v41, v38, v39
  buffer_store_dwordx2 v[40:41], v28, s[28:31], s39 offen
L_end:
  s_endpgm
L_pub:
  s_memrealtime s[42:43]
  s_waitcnt lgkmcnt(0)
  s_or_b32 s42, s42, 1
  v_mov_b32 v34, s42
  buffer_store_dword v34, v1, s[56:59], s62 offen offset:0 sc0 sc1
  s_branch L_kc
L_pub2:
  s_memrealtime s[42:43]
  s_waitcnt lgkmcnt(0)
  s_or_b32 s42, s42, 1
  v_mov_b32 v34, s42
  buffer_store_dword v34, v1, s[56:59], s62 offen offset:4 sc0 sc1
  s_branch L_kc
L_pub3:
  s_memrealtime s[42:43]
  s_waitcnt lgkmcnt(0)
  s_or_b32 s42, s42, 1
  v_mov_b32 v34, s42
  buffer_store_dword v34, v1, s[56:59], s62 offen offset:0 sc0 sc1
  s_sub_u32 s60, s60, 16
  s_cmp_lt_i32 s60, 26
  s_cselect_b32 s60, -1, s60
  s_branch L_vd
L_fetch:
  v_lshlrev_b32 v34, 2, v0
  buffer_load_dword v35, v34, s[56:59], 0 offen sc0 sc1
  s_branch L_kc
L_fetch2:
  v_lshlrev_b32 v34, 2, v0
  buffer_load_dword v35, v34, s[56:59], 0 offen sc0 sc1
  s_branch L_vd
L_anchor:
  v_subrev_u32 v35, s64, v35
  v_cmp_gt_i32 vcc, s77, v35
  s_nop 1
  v_add_u32_dpp v35, v35, v35 row_ror:2 row_mask:0xf bank_mask:0xf
  s_nop 1
  v_add_u32_dpp v35, v35, v35 row_ror:4 row_mask:0xf bank_mask:0xf
  s_nop 1
  v_add_u32_dpp v35, v35, v35 row_ror:8 row_mask:0xf bank_mask:0xf
  s_nop 1
  v_readlane_b32 s40, v35, 0
  v_readlane_b32 s41, v35, 16
  v_readlane_b32 s42, v35, 32
  v_readlane_b32 s43, v35, 48
  s_and_b32 vcc_lo, vcc_lo, 0x55555555
  s_and_b32 vcc_hi, vcc_hi, 0x55555555
  s_sub_u32 s61, s61, 16
  s_cmp_lt_i32 s61, 17
  s_cselect_b32 s61, -2, s61
  s_add_i32 s40, s40, s41
  s_add_i32 s40, s40, s42
  s_add_i32 s40, s40, s43
  s_ashr_i32 s40, s40, 1
  s_sub_u32 s77, s68, s64
  s_cmp_eq_u32 s66, 0
  s_cbranch_scc1 L_vd
  s_cmp_lg_u64 vcc, 0
  s_cbranch_scc1 L_stale
  s_sub_i32 s41, s40, s78
  s_mul_i32 s41, s41, s79
  s_ashr_i32 s41, s41, 16
  s_cmp_eq_u32 s79, 0
  s_cselect_b32 s41, s66, s41
  s_min_i32 s66, s66, s41
  s_mov_b32 s78, s40
  s_mov_b32 s79, 4096
  s_mul_i32 s41, s66, 9
  s_add_i32 s70, s40, s41
  s_add_i32 s70, s70, 1360
  s_branch L_vd
L_stale:
  s_mov_b32 s79, 0
  s_branch L_vd
.section .rodata,"a"
.p2align 6
.amdhsa_kernel standalone__mha_softmax__sampling_kernel
  .amdhsa_next_free_vgpr 192
  .amdhsa_next_free_sgpr 88
  .amdhsa_accum_offset 192
  .amdhsa_group_segment_fixed_size 0
  .amdhsa_kernarg_size 48
  .amdhsa_user_sgpr_count 2
  .amdhsa_user_sgpr_kernarg_segment_ptr 1
  .amdhsa_system_sgpr_workgroup_id_x 1
  .amdhsa_float_denorm_mode_32 3
.end_amdhsa_kernel
```
